```python
import torch

def _softmax(x, axis=-1):
    return torch.softmax(x, dim=axis)
def _gelu(x):
    return torch.nn.functional.gelu(x, approximate="tanh")
def _silu(x):
    return torch.nn.functional.silu(x)
def _sigmoid(x):
    return torch.sigmoid(x)
def _layernorm(x, axis=-1, eps=1e-5):
    m = x.mean(dim=axis, keepdim=True)
    v = x.var(dim=axis, keepdim=True, unbiased=False)
    return (x - m) / torch.sqrt(v + eps)
def _scatter_add(tgt, idx, src, axis=0):
    return tgt.clone().index_add_(axis, idx, src)
def _segment_sum(src, seg, n):
    out = torch.zeros((n,) + src.shape[1:], dtype=src.dtype)
    return out.index_add_(0, seg, src)
def _pad(x, pw):
    flat = tuple(v for pair in reversed(pw) for v in pair)
    return torch.nn.functional.pad(x, flat)

kernel_name = 'standalone__groupnorm__sampling'

def setup_inputs():

    _w = (lambda a: (lambda t: t.to(torch.bfloat16) if t.is_floating_point() else t)(torch.as_tensor(a)))
    B = 16
    G = 32
    cpg = max(1, 512 // G)
    C = G * cpg
    H, W = 32, 32
    return {
        "x": _w(abs((lambda *s: torch.randn(*s, dtype=torch.bfloat16) * 0.05)(B, C, H, W))),
        "g": _w((lambda *s: torch.randn(*s, dtype=torch.bfloat16) * 0.05)(C) + 1.0),
        "b": _w((lambda *s: torch.randn(*s, dtype=torch.bfloat16) * 0.4)(C)),
    }

def reference(x, g, b):
    G = 32
    B, C, H, W = x.shape[0], x.shape[1], x.shape[2], x.shape[3]
    xr = x.reshape(B, G, C // G, H, W)
    mu = xr.mean(axis=(2, 3, 4), keepdims=True)
    var = ((xr - mu) ** 2).mean(axis=(2, 3, 4), keepdims=True)
    xn = (xr - mu) / torch.sqrt(var + 1e-5)
    xn = xn.reshape(B, C, H, W)
    return xn * g[None, :, None, None] + b[None, :, None, None]
```

```asm
; @launch grid=(512,1,1) block=(256,1,1) lds=32
.amdgcn_target "amdgcn-amd-amdhsa--gfx950"
.text
.p2align 13
.globl standalone__groupnorm__sampling_kernel
.p2align 8
.type standalone__groupnorm__sampling_kernel,@function
standalone__groupnorm__sampling_kernel:
    s_load_dwordx8 s[4:11], s[0:1], 0
    s_cmp_ge_u32 s2, 512
    s_cbranch_scc1 L_end
    s_and_b32 s3, s2, 0x20
    s_mulk_i32 s3, 0x2200
    s_and_b32 s12, s2, 0x8
    s_lshl_b32 s12, s12, 12
    s_or_b32 s3, s3, s12
    s_and_b32 s12, s2, 0xc0
    s_lshl_b32 s12, s12, 14
    s_or_b32 s3, s3, s12
    s_and_b32 s12, s2, 0x10
    s_lshl_b32 s12, s12, 15
    s_or_b32 s3, s3, s12
    s_and_b32 s12, s2, 0x3
    s_lshl_b32 s12, s12, 16
    s_or_b32 s3, s3, s12
    s_and_b32 s12, s2, 0x4
    s_lshl_b32 s12, s12, 21
    s_or_b32 s3, s3, s12
    s_bitcmp1_b32 s2, 8
    s_cselect_b32 s12, 0x50e000, 0
    s_xor_b32 s3, s3, s12
    s_bitset1_b32 s3, 12
    v_and_b32 v2, 192, v0
    v_mad_u32_u24 v1, v2, 7, v0
    v_lshlrev_b32 v1, 4, v1
    v_xor_b32 v1, s3, v1
    s_bitcmp1_b32 s2, 8
    v_readfirstlane_b32 s14, v1
    s_cbranch_scc1 L_load_b
    s_waitcnt lgkmcnt(0)
    global_load_dwordx4 v[16:19], v1, s[4:5] offset:-4096 nt
    global_load_dwordx4 v[20:23], v1, s[4:5] offset:-3072 nt
    global_load_dwordx4 v[24:27], v1, s[4:5] offset:-2048 nt
    global_load_dwordx4 v[28:31], v1, s[4:5] offset:-1024 nt
    global_load_dwordx4 v[32:35], v1, s[4:5] offset:0 nt
    global_load_dwordx4 v[36:39], v1, s[4:5] offset:1024 nt
    global_load_dwordx4 v[40:43], v1, s[4:5] offset:2048 nt
    global_load_dwordx4 v[44:47], v1, s[4:5] offset:3072 nt
    s_branch L_loaded
L_load_b:
    s_waitcnt lgkmcnt(0)
    global_load_dwordx4 v[16:19], v1, s[4:5] offset:-4096
    global_load_dwordx4 v[20:23], v1, s[4:5] offset:-3072
    global_load_dwordx4 v[24:27], v1, s[4:5] offset:-2048
    global_load_dwordx4 v[28:31], v1, s[4:5] offset:-1024
    global_load_dwordx4 v[32:35], v1, s[4:5] offset:0
    global_load_dwordx4 v[36:39], v1, s[4:5] offset:1024
    global_load_dwordx4 v[40:43], v1, s[4:5] offset:2048
    global_load_dwordx4 v[44:47], v1, s[4:5] offset:3072
L_loaded:
    s_load_dword s16, s[4:5], s3
    v_lshrrev_b32 v2, 5, v0
    v_lshlrev_b32 v2, 2, v2
    v_and_b32 v3, 1, v0
    v_lshlrev_b32 v3, 4, v3
    s_movk_i32 s18, 0x3f80
    s_mov_b32 s19, 1.0
    s_brev_b32 s24, 1
    s_brev_b32 s25, 1
    s_or_b32 s17, s18, s19
    v_mov_b32 v6, 0
    s_waitcnt lgkmcnt(0)
    v_lshlrev_b32_e64 v4, 16, s16
    s_lshr_b32 s14, s14, 10
    s_and_b32 s14, s14, 0x3f8
    s_load_dwordx2 s[20:21], s[6:7], s14
    s_load_dwordx2 s[22:23], s[8:9], s14
    s_waitcnt vmcnt(7)
    v_dot2c_f32_bf16 v6, s17, v16
    v_dot2_f32_bf16 v48, v16, s18, v4 neg_lo:[0,0,1]
    v_dot2_f32_bf16 v49, v16, s19, v4 neg_lo:[0,0,1]
    v_dot2_f32_bf16 v50, v17, s18, v4 neg_lo:[0,0,1]
    v_dot2_f32_bf16 v51, v17, s19, v4 neg_lo:[0,0,1]
    v_dot2_f32_bf16 v52, v18, s18, v4 neg_lo:[0,0,1]
    v_dot2_f32_bf16 v53, v18, s19, v4 neg_lo:[0,0,1]
    v_dot2_f32_bf16 v54, v19, s18, v4 neg_lo:[0,0,1]
    v_dot2_f32_bf16 v55, v19, s19, v4 neg_lo:[0,0,1]
    v_dot2c_f32_bf16 v6, s17, v17
    v_dot2c_f32_bf16 v6, s17, v18
    v_pk_mul_f32 v[8:9], v[48:49], v[48:49]
    v_pk_fma_f32 v[8:9], v[50:51], v[50:51], v[8:9]
    v_pk_fma_f32 v[8:9], v[52:53], v[52:53], v[8:9]
    v_pk_fma_f32 v[8:9], v[54:55], v[54:55], v[8:9]
    v_dot2c_f32_bf16 v6, s17, v19
    s_waitcnt vmcnt(6)
    v_dot2_f32_bf16 v56, v20, s18, v4 neg_lo:[0,0,1]
    v_dot2_f32_bf16 v57, v20, s19, v4 neg_lo:[0,0,1]
    v_dot2_f32_bf16 v58, v21, s18, v4 neg_lo:[0,0,1]
    v_dot2_f32_bf16 v59, v21, s19, v4 neg_lo:[0,0,1]
    v_dot2_f32_bf16 v60, v22, s18, v4 neg_lo:[0,0,1]
    v_dot2_f32_bf16 v61, v22, s19, v4 neg_lo:[0,0,1]
    v_dot2_f32_bf16 v62, v23, s18, v4 neg_lo:[0,0,1]
    v_dot2_f32_bf16 v63, v23, s19, v4 neg_lo:[0,0,1]
    v_dot2c_f32_bf16 v6, s17, v20
    v_dot2c_f32_bf16 v6, s17, v21
    v_dot2c_f32_bf16 v6, s17, v22
    v_dot2c_f32_bf16 v6, s17, v23
    v_pk_fma_f32 v[8:9], v[56:57], v[56:57], v[8:9]
    v_pk_fma_f32 v[8:9], v[58:59], v[58:59], v[8:9]
    v_pk_fma_f32 v[8:9], v[60:61], v[60:61], v[8:9]
    v_pk_fma_f32 v[8:9], v[62:63], v[62:63], v[8:9]
    s_waitcnt vmcnt(5)
    v_dot2c_f32_bf16 v6, s17, v24
    v_dot2_f32_bf16 v64, v24, s18, v4 neg_lo:[0,0,1]
    v_dot2_f32_bf16 v65, v24, s19, v4 neg_lo:[0,0,1]
    v_dot2_f32_bf16 v66, v25, s18, v4 neg_lo:[0,0,1]
    v_dot2_f32_bf16 v67, v25, s19, v4 neg_lo:[0,0,1]
    v_dot2_f32_bf16 v68, v26, s18, v4 neg_lo:[0,0,1]
    v_dot2_f32_bf16 v69, v26, s19, v4 neg_lo:[0,0,1]
    v_dot2_f32_bf16 v70, v27, s18, v4 neg_lo:[0,0,1]
    v_dot2_f32_bf16 v71, v27, s19, v4 neg_lo:[0,0,1]
    v_dot2c_f32_bf16 v6, s17, v25
    v_dot2c_f32_bf16 v6, s17, v26
    v_pk_fma_f32 v[8:9], v[64:65], v[64:65], v[8:9]
    v_pk_fma_f32 v[8:9], v[66:67], v[66:67], v[8:9]
    v_pk_fma_f32 v[8:9], v[68:69], v[68:69], v[8:9]
    v_pk_fma_f32 v[8:9], v[70:71], v[70:71], v[8:9]
    v_dot2c_f32_bf16 v6, s17, v27
    s_waitcnt vmcnt(4)
    v_dot2_f32_bf16 v72, v28, s18, v4 neg_lo:[0,0,1]
    v_dot2_f32_bf16 v73, v28, s19, v4 neg_lo:[0,0,1]
    v_dot2_f32_bf16 v74, v29, s18, v4 neg_lo:[0,0,1]
    v_dot2_f32_bf16 v75, v29, s19, v4 neg_lo:[0,0,1]
    v_dot2_f32_bf16 v76, v30, s18, v4 neg_lo:[0,0,1]
    v_dot2_f32_bf16 v77, v30, s19, v4 neg_lo:[0,0,1]
    v_dot2_f32_bf16 v78, v31, s18, v4 neg_lo:[0,0,1]
    v_dot2_f32_bf16 v79, v31, s19, v4 neg_lo:[0,0,1]
    v_dot2c_f32_bf16 v6, s17, v28
    v_dot2c_f32_bf16 v6, s17, v29
    v_dot2c_f32_bf16 v6, s17, v30
    v_dot2c_f32_bf16 v6, s17, v31
    v_pk_fma_f32 v[8:9], v[72:73], v[72:73], v[8:9]
    v_pk_fma_f32 v[8:9], v[74:75], v[74:75], v[8:9]
    v_pk_fma_f32 v[8:9], v[76:77], v[76:77], v[8:9]
    v_pk_fma_f32 v[8:9], v[78:79], v[78:79], v[8:9]
    s_waitcnt vmcnt(3)
    v_dot2c_f32_bf16 v6, s17, v32
    v_dot2_f32_bf16 v80, v32, s18, v4 neg_lo:[0,0,1]
    v_dot2_f32_bf16 v81, v32, s19, v4 neg_lo:[0,0,1]
    v_dot2_f32_bf16 v82, v33, s18, v4 neg_lo:[0,0,1]
    v_dot2_f32_bf16 v83, v33, s19, v4 neg_lo:[0,0,1]
    v_dot2_f32_bf16 v84, v34, s18, v4 neg_lo:[0,0,1]
    v_dot2_f32_bf16 v85, v34, s19, v4 neg_lo:[0,0,1]
    v_dot2_f32_bf16 v86, v35, s18, v4 neg_lo:[0,0,1]
    v_dot2_f32_bf16 v87, v35, s19, v4 neg_lo:[0,0,1]
    v_dot2c_f32_bf16 v6, s17, v33
    v_dot2c_f32_bf16 v6, s17, v34
    v_pk_fma_f32 v[8:9], v[80:81], v[80:81], v[8:9]
    v_pk_fma_f32 v[8:9], v[82:83], v[82:83], v[8:9]
    v_pk_fma_f32 v[8:9], v[84:85], v[84:85], v[8:9]
    v_pk_fma_f32 v[8:9], v[86:87], v[86:87], v[8:9]
    v_dot2c_f32_bf16 v6, s17, v35
    s_waitcnt vmcnt(2)
    v_dot2_f32_bf16 v88, v36, s18, v4 neg_lo:[0,0,1]
    v_dot2_f32_bf16 v89, v36, s19, v4 neg_lo:[0,0,1]
    v_dot2_f32_bf16 v90, v37, s18, v4 neg_lo:[0,0,1]
    v_dot2_f32_bf16 v91, v37, s19, v4 neg_lo:[0,0,1]
    v_dot2_f32_bf16 v92, v38, s18, v4 neg_lo:[0,0,1]
    v_dot2_f32_bf16 v93, v38, s19, v4 neg_lo:[0,0,1]
    v_dot2_f32_bf16 v94, v39, s18, v4 neg_lo:[0,0,1]
    v_dot2_f32_bf16 v95, v39, s19, v4 neg_lo:[0,0,1]
    v_dot2c_f32_bf16 v6, s17, v36
    v_dot2c_f32_bf16 v6, s17, v37
    v_dot2c_f32_bf16 v6, s17, v38
    v_dot2c_f32_bf16 v6, s17, v39
    v_pk_fma_f32 v[8:9], v[88:89], v[88:89], v[8:9]
    v_pk_fma_f32 v[8:9], v[90:91], v[90:91], v[8:9]
    v_pk_fma_f32 v[8:9], v[92:93], v[92:93], v[8:9]
    v_pk_fma_f32 v[8:9], v[94:95], v[94:95], v[8:9]
    s_waitcnt vmcnt(1)
    v_dot2c_f32_bf16 v6, s17, v40
    v_dot2_f32_bf16 v96, v40, s18, v4 neg_lo:[0,0,1]
    v_dot2_f32_bf16 v97, v40, s19, v4 neg_lo:[0,0,1]
    v_dot2_f32_bf16 v98, v41, s18, v4 neg_lo:[0,0,1]
    v_dot2_f32_bf16 v99, v41, s19, v4 neg_lo:[0,0,1]
    v_dot2_f32_bf16 v100, v42, s18, v4 neg_lo:[0,0,1]
    v_dot2_f32_bf16 v101, v42, s19, v4 neg_lo:[0,0,1]
    v_dot2_f32_bf16 v102, v43, s18, v4 neg_lo:[0,0,1]
    v_dot2_f32_bf16 v103, v43, s19, v4 neg_lo:[0,0,1]
    v_dot2c_f32_bf16 v6, s17, v41
    v_dot2c_f32_bf16 v6, s17, v42
    v_pk_fma_f32 v[8:9], v[96:97], v[96:97], v[8:9]
    v_pk_fma_f32 v[8:9], v[98:99], v[98:99], v[8:9]
    v_pk_fma_f32 v[8:9], v[100:101], v[100:101], v[8:9]
    v_pk_fma_f32 v[8:9], v[102:103], v[102:103], v[8:9]
    v_dot2c_f32_bf16 v6, s17, v43
    s_waitcnt vmcnt(0)
    v_dot2_f32_bf16 v104, v44, s18, v4 neg_lo:[0,0,1]
    v_dot2_f32_bf16 v105, v44, s19, v4 neg_lo:[0,0,1]
    v_dot2_f32_bf16 v106, v45, s18, v4 neg_lo:[0,0,1]
    v_dot2_f32_bf16 v107, v45, s19, v4 neg_lo:[0,0,1]
    v_dot2_f32_bf16 v108, v46, s18, v4 neg_lo:[0,0,1]
    v_dot2_f32_bf16 v109, v46, s19, v4 neg_lo:[0,0,1]
    v_dot2_f32_bf16 v110, v47, s18, v4 neg_lo:[0,0,1]
    v_dot2_f32_bf16 v111, v47, s19, v4 neg_lo:[0,0,1]
    v_dot2c_f32_bf16 v6, s17, v44
    v_dot2c_f32_bf16 v6, s17, v45
    v_dot2c_f32_bf16 v6, s17, v46
    v_dot2c_f32_bf16 v6, s17, v47
    v_pk_fma_f32 v[8:9], v[104:105], v[104:105], v[8:9]
    v_pk_fma_f32 v[8:9], v[106:107], v[106:107], v[8:9]
    v_pk_fma_f32 v[8:9], v[108:109], v[108:109], v[8:9]
    v_pk_fma_f32 v[8:9], v[110:111], v[110:111], v[8:9]
    v_add_f32 v8, v8, v9
    s_nop 1
    v_permlane32_swap_b32 v6, v8
    v_add_f32 v6, v6, v8
    s_nop 1
    v_add_f32_dpp v6, v6, v6 quad_perm:[1,0,3,2] row_mask:0xf bank_mask:0xf
    s_nop 1
    v_add_f32_dpp v6, v6, v6 quad_perm:[2,3,0,1] row_mask:0xf bank_mask:0xf
    s_nop 1
    v_add_f32_dpp v6, v6, v6 row_half_mirror row_mask:0xf bank_mask:0xf
    s_nop 1
    v_add_f32_dpp v6, v6, v6 row_mirror row_mask:0xf bank_mask:0xf
    s_nop 1
    v_add_f32_dpp v6, v6, v6 row_bcast:15 row_mask:0xa bank_mask:0xf
    s_mov_b64 exec, s[24:25]
    ds_write_b32 v2, v6
    s_mov_b64 exec, -1
    s_waitcnt lgkmcnt(0)
    s_barrier
    ds_read_b128 v[8:11], v3
    v_mov_b32 v14, 0x38800000
    s_lshl_b32 s28, s20, 16
    s_lshl_b32 s32, s22, 16
    s_pack_lh_b32_b16 s29, 0, s20
    s_pack_lh_b32_b16 s33, 0, s22
    s_lshl_b32 s30, s21, 16
    s_lshl_b32 s34, s23, 16
    s_pack_lh_b32_b16 s31, 0, s21
    s_pack_lh_b32_b16 s35, 0, s23
    s_waitcnt lgkmcnt(0)
    v_pk_add_f32 v[8:9], v[8:9], v[10:11]
    s_nop 1
    v_add_f32_dpp v8, v8, v8 quad_perm:[1,0,3,2] row_mask:0xf bank_mask:0xf
    v_add_f32_dpp v9, v9, v9 quad_perm:[1,0,3,2] row_mask:0xf bank_mask:0xf
    v_cvt_pk_bf16_f32 v10, 0, v8
    v_fma_f32 v11, v8, v14, -v4
    v_fmaak_f32 v5, v9, v14, 0x3727c5ac
    v_fma_f32 v10, v10, v14, -v4
    v_fma_f32 v11, -2.0, v11, v10
    v_fmac_f32 v5, v10, v11
    v_rsq_f32_e64 v11, abs(v5)
    s_nop 0
    v_mul_f32 v12, s28, v11
    v_fma_f32 v13, -v10, v12, s32
    v_pk_fma_f32 v[48:49], v[48:49], v[12:13], v[12:13] op_sel:[0,0,1] op_sel_hi:[1,0,1]
    v_pk_fma_f32 v[50:51], v[50:51], v[12:13], v[12:13] op_sel:[0,0,1] op_sel_hi:[1,0,1]
    v_pk_fma_f32 v[52:53], v[52:53], v[12:13], v[12:13] op_sel:[0,0,1] op_sel_hi:[1,0,1]
    v_pk_fma_f32 v[54:55], v[54:55], v[12:13], v[12:13] op_sel:[0,0,1] op_sel_hi:[1,0,1]
    v_cvt_pk_bf16_f32 v16, v48, v49
    v_cvt_pk_bf16_f32 v17, v50, v51
    v_cvt_pk_bf16_f32 v18, v52, v53
    v_cvt_pk_bf16_f32 v19, v54, v55
    global_store_dwordx4 v1, v[16:19], s[10:11] offset:-4096 nt
    v_pk_fma_f32 v[56:57], v[56:57], v[12:13], v[12:13] op_sel:[0,0,1] op_sel_hi:[1,0,1]
    v_pk_fma_f32 v[58:59], v[58:59], v[12:13], v[12:13] op_sel:[0,0,1] op_sel_hi:[1,0,1]
    v_pk_fma_f32 v[60:61], v[60:61], v[12:13], v[12:13] op_sel:[0,0,1] op_sel_hi:[1,0,1]
    v_pk_fma_f32 v[62:63], v[62:63], v[12:13], v[12:13] op_sel:[0,0,1] op_sel_hi:[1,0,1]
    v_cvt_pk_bf16_f32 v20, v56, v57
    v_cvt_pk_bf16_f32 v21, v58, v59
    v_cvt_pk_bf16_f32 v22, v60, v61
    v_cvt_pk_bf16_f32 v23, v62, v63
    global_store_dwordx4 v1, v[20:23], s[10:11] offset:-3072 nt
    v_mul_f32 v14, s29, v11
    v_fma_f32 v15, -v10, v14, s33
    v_pk_fma_f32 v[64:65], v[64:65], v[14:15], v[14:15] op_sel:[0,0,1] op_sel_hi:[1,0,1]
    v_pk_fma_f32 v[66:67], v[66:67], v[14:15], v[14:15] op_sel:[0,0,1] op_sel_hi:[1,0,1]
    v_pk_fma_f32 v[68:69], v[68:69], v[14:15], v[14:15] op_sel:[0,0,1] op_sel_hi:[1,0,1]
    v_pk_fma_f32 v[70:71], v[70:71], v[14:15], v[14:15] op_sel:[0,0,1] op_sel_hi:[1,0,1]
    v_cvt_pk_bf16_f32 v24, v64, v65
    v_cvt_pk_bf16_f32 v25, v66, v67
    v_cvt_pk_bf16_f32 v26, v68, v69
    v_cvt_pk_bf16_f32 v27, v70, v71
    global_store_dwordx4 v1, v[24:27], s[10:11] offset:-2048 nt
    v_pk_fma_f32 v[72:73], v[72:73], v[14:15], v[14:15] op_sel:[0,0,1] op_sel_hi:[1,0,1]
    v_pk_fma_f32 v[74:75], v[74:75], v[14:15], v[14:15] op_sel:[0,0,1] op_sel_hi:[1,0,1]
    v_pk_fma_f32 v[76:77], v[76:77], v[14:15], v[14:15] op_sel:[0,0,1] op_sel_hi:[1,0,1]
    v_pk_fma_f32 v[78:79], v[78:79], v[14:15], v[14:15] op_sel:[0,0,1] op_sel_hi:[1,0,1]
    v_cvt_pk_bf16_f32 v28, v72, v73
    v_cvt_pk_bf16_f32 v29, v74, v75
    v_cvt_pk_bf16_f32 v30, v76, v77
    v_cvt_pk_bf16_f32 v31, v78, v79
    global_store_dwordx4 v1, v[28:31], s[10:11] offset:-1024 nt
    v_mul_f32 v12, s30, v11
    v_fma_f32 v13, -v10, v12, s34
    v_pk_fma_f32 v[80:81], v[80:81], v[12:13], v[12:13] op_sel:[0,0,1] op_sel_hi:[1,0,1]
    v_pk_fma_f32 v[82:83], v[82:83], v[12:13], v[12:13] op_sel:[0,0,1] op_sel_hi:[1,0,1]
    v_pk_fma_f32 v[84:85], v[84:85], v[12:13], v[12:13] op_sel:[0,0,1] op_sel_hi:[1,0,1]
    v_pk_fma_f32 v[86:87], v[86:87], v[12:13], v[12:13] op_sel:[0,0,1] op_sel_hi:[1,0,1]
    v_cvt_pk_bf16_f32 v32, v80, v81
    v_cvt_pk_bf16_f32 v33, v82, v83
    v_cvt_pk_bf16_f32 v34, v84, v85
    v_cvt_pk_bf16_f32 v35, v86, v87
    global_store_dwordx4 v1, v[32:35], s[10:11] offset:0 nt
    v_pk_fma_f32 v[88:89], v[88:89], v[12:13], v[12:13] op_sel:[0,0,1] op_sel_hi:[1,0,1]
    v_pk_fma_f32 v[90:91], v[90:91], v[12:13], v[12:13] op_sel:[0,0,1] op_sel_hi:[1,0,1]
    v_pk_fma_f32 v[92:93], v[92:93], v[12:13], v[12:13] op_sel:[0,0,1] op_sel_hi:[1,0,1]
    v_pk_fma_f32 v[94:95], v[94:95], v[12:13], v[12:13] op_sel:[0,0,1] op_sel_hi:[1,0,1]
    v_cvt_pk_bf16_f32 v36, v88, v89
    v_cvt_pk_bf16_f32 v37, v90, v91
    v_cvt_pk_bf16_f32 v38, v92, v93
    v_cvt_pk_bf16_f32 v39, v94, v95
    global_store_dwordx4 v1, v[36:39], s[10:11] offset:1024 nt
    v_mul_f32 v14, s31, v11
    v_fma_f32 v15, -v10, v14, s35
    v_pk_fma_f32 v[96:97], v[96:97], v[14:15], v[14:15] op_sel:[0,0,1] op_sel_hi:[1,0,1]
    v_pk_fma_f32 v[98:99], v[98:99], v[14:15], v[14:15] op_sel:[0,0,1] op_sel_hi:[1,0,1]
    v_pk_fma_f32 v[100:101], v[100:101], v[14:15], v[14:15] op_sel:[0,0,1] op_sel_hi:[1,0,1]
    v_pk_fma_f32 v[102:103], v[102:103], v[14:15], v[14:15] op_sel:[0,0,1] op_sel_hi:[1,0,1]
    v_cvt_pk_bf16_f32 v40, v96, v97
    v_cvt_pk_bf16_f32 v41, v98, v99
    v_cvt_pk_bf16_f32 v42, v100, v101
    v_cvt_pk_bf16_f32 v43, v102, v103
    global_store_dwordx4 v1, v[40:43], s[10:11] offset:2048 nt
    v_pk_fma_f32 v[104:105], v[104:105], v[14:15], v[14:15] op_sel:[0,0,1] op_sel_hi:[1,0,1]
    v_pk_fma_f32 v[106:107], v[106:107], v[14:15], v[14:15] op_sel:[0,0,1] op_sel_hi:[1,0,1]
    v_pk_fma_f32 v[108:109], v[108:109], v[14:15], v[14:15] op_sel:[0,0,1] op_sel_hi:[1,0,1]
    v_pk_fma_f32 v[110:111], v[110:111], v[14:15], v[14:15] op_sel:[0,0,1] op_sel_hi:[1,0,1]
    v_cvt_pk_bf16_f32 v44, v104, v105
    v_cvt_pk_bf16_f32 v45, v106, v107
    v_cvt_pk_bf16_f32 v46, v108, v109
    v_cvt_pk_bf16_f32 v47, v110, v111
    global_store_dwordx4 v1, v[44:47], s[10:11] offset:3072 nt
L_end:
    s_endpgm
.section .rodata,"a"
.p2align 6
.amdhsa_kernel standalone__groupnorm__sampling_kernel
  .amdhsa_next_free_vgpr 112
  .amdhsa_next_free_sgpr 40
  .amdhsa_accum_offset 112
  .amdhsa_group_segment_fixed_size 0
  .amdhsa_kernarg_size 48
  .amdhsa_user_sgpr_count 2
  .amdhsa_user_sgpr_kernarg_segment_ptr 1
  .amdhsa_system_sgpr_workgroup_id_x 1
  .amdhsa_float_denorm_mode_32 3
.end_amdhsa_kernel
```
